```python
import torch

def _softmax(x, axis=-1):
    return torch.softmax(x, dim=axis)
def _gelu(x):
    return torch.nn.functional.gelu(x, approximate="tanh")
def _silu(x):
    return torch.nn.functional.silu(x)
def _sigmoid(x):
    return torch.sigmoid(x)
def _layernorm(x, axis=-1, eps=1e-5):
    m = x.mean(dim=axis, keepdim=True)
    v = x.var(dim=axis, keepdim=True, unbiased=False)
    return (x - m) / torch.sqrt(v + eps)
def _scatter_add(tgt, idx, src, axis=0):
    return tgt.clone().index_add_(axis, idx, src)
def _segment_sum(src, seg, n):
    out = torch.zeros((n,) + src.shape[1:], dtype=src.dtype)
    return out.index_add_(0, seg, src)
def _pad(x, pw):
    flat = tuple(v for pair in reversed(pw) for v in pair)
    return torch.nn.functional.pad(x, flat)

kernel_name = 'sequential_preLN__sliding_block_cached__glu_gated_swiglu__decode'

def setup_inputs():

    _w = (lambda a: (lambda t: t.to(torch.bfloat16) if t.is_floating_point() else t)(torch.as_tensor(a)))
    def _A_setup():
        B, Sq, D = 1, 1, 512
        Hq, Hkv, Sk, Dh = 32, 8, 32768, 128
        assert Hq % Hkv == 0, (Hq, Hkv)
        return {
            "x": _w((lambda *s: torch.randn(*s, dtype=torch.bfloat16) * 0.05)(B, Sq, D)),
            "k_cache": _w((lambda *s: torch.randn(*s, dtype=torch.bfloat16) * 1.6)(B, Hkv, Sk, Dh)),
            "v_cache": _w((lambda *s: torch.randn(*s, dtype=torch.bfloat16) * 0.8)(B, Hkv, Sk, Dh)),
            "wq": _w((lambda *s: torch.randn(*s, dtype=torch.bfloat16) * 1.6)(D, Hq * Dh) * (D ** -0.5)),
            "wo": _w((lambda *s: torch.randn(*s, dtype=torch.bfloat16) * 0.8)(Hq * Dh, D) * ((Hq * Dh) ** -0.5)),
        }
    _A_in = _A_setup()

    def _B_setup():
        B, S, D, F = 1, 1, 512, 1792
        return {
            "x": _w((lambda *s: torch.randn(*s, dtype=torch.bfloat16) * 0.05)(B, S, D)),
            "w1": _w((lambda *s: torch.randn(*s, dtype=torch.bfloat16) * 0.4)(D, F) * (2.0 / D) ** 0.5),
            "w3": _w((lambda *s: torch.randn(*s, dtype=torch.bfloat16) * 0.4)(D, F) * (2.0 / D) ** 0.5),
            "w2": _w((lambda *s: torch.randn(*s, dtype=torch.bfloat16) * 0.4)(F, D) * (2.0 / F) ** 0.5),
        }
    _B_in = _B_setup()

    return {
        "A_x": _A_in["x"],
        "A_k_cache": _A_in["k_cache"],
        "A_v_cache": _A_in["v_cache"],
        "A_wq": _A_in["wq"],
        "A_wo": _A_in["wo"],
        "B_x": _B_in["x"],
        "B_w1": _B_in["w1"],
        "B_w3": _B_in["w3"],
        "B_w2": _B_in["w2"],
    }

def reference(A_x, A_k_cache, A_v_cache, A_wq, A_wo, B_x, B_w1, B_w3, B_w2):
    def _A_ref(x, k_cache, v_cache, wq, wo):
        B, Sq, D = x.shape
        Hq, Dh = 32, 128
        Hkv, Sk = k_cache.shape[1], k_cache.shape[2]
        W = min(4096, max(256, Sk // 4))
        rep = Hq // Hkv
        q = (lambda x, *d: x.permute(*d))((x @ wq).reshape(B, Sq, Hq, Dh), 0, 2, 1, 3)
        k = (lambda x, n, axis: torch.repeat_interleave(x, n, dim=axis))(k_cache[:, :, Sk - W:, :], rep, axis=1)
        v = (lambda x, n, axis: torch.repeat_interleave(x, n, dim=axis))(v_cache[:, :, Sk - W:, :], rep, axis=1)
        scores = torch.einsum("bhqd,bhkd->bhqk", q, k) * (Dh ** -0.5)
        p = _softmax(scores, axis=-1)
        o = torch.einsum("bhqk,bhkd->bhqd", p, v)
        return (lambda x, *d: x.permute(*d))(o, 0, 2, 1, 3).reshape(B, Sq, Hq * Dh) @ wo

    def _B_ref(x, w1, w3, w2):
        gate = torch.einsum("bsd,df->bsf", x, w1)
        up = torch.einsum("bsd,df->bsf", x, w3)
        h = _silu(gate) * up
        out = torch.einsum("bsf,fd->bsd", h, w2)
        return out

    x = A_x
    h = x + _A_ref(_layernorm(x, axis=-1), A_k_cache, A_v_cache, A_wq, A_wo)
    h2 = h + _B_ref(_layernorm(h, axis=-1), B_w1, B_w3, B_w2)
    return h2
```

```asm
; @launch grid=(256,1,1) block=(576,1,1) lds=78208
.amdgcn_target "amdgcn-amd-amdhsa--gfx950"
.text
.p2align 12
.globl sequential_preLN__sliding_block_cached__glu_gated_swiglu__decode_kernel
.p2align 8
.type sequential_preLN__sliding_block_cached__glu_gated_swiglu__decode_kernel,@function
sequential_preLN__sliding_block_cached__glu_gated_swiglu__decode_kernel:
    s_cmp_ge_u32 s2, 256
    s_cbranch_scc1 L_end
    v_lshrrev_b32 v1, 6, v0
    s_and_b32 s4, s2, 7
    v_readfirstlane_b32 s3, v1
    s_lshr_b32 s5, s2, 3
    v_and_b32 v0, 63, v0
    s_cmp_gt_u32 s3, 4
    s_cbranch_scc1 L_T
    s_load_dwordx2 s[44:45], s[0:1], 88
    s_mov_b32 s46, 0x10000000
    s_mov_b32 s47, 0x20000
    s_cmp_eq_u32 s3, 4
    s_cbranch_scc1 L_Z
    s_load_dwordx2 s[8:9], s[0:1], 0
    s_load_dwordx2 s[20:21], s[0:1], 24
    s_load_dwordx2 s[12:13], s[0:1], 8
    s_load_dwordx2 s[16:17], s[0:1], 16
    s_mov_b32 s10, 0x400
    s_mov_b32 s11, 0x20000
    s_mov_b32 s22, 0x400000
    s_mov_b32 s23, 0x20000
    s_mov_b32 s14, 0x4000000
    s_mov_b32 s15, 0x20000
    s_mov_b32 s18, 0x4000000
    s_mov_b32 s19, 0x20000
    v_lshrrev_b32 v36, 4, v0
    v_and_b32 v37, 15, v0
    v_lshlrev_b32 v38, 1, v36
    v_and_b32 v39, 7, v0
    v_xor_b32 v38, v38, v39
    v_lshlrev_b32 v38, 4, v38
    v_lshrrev_b32 v39, 3, v0
    v_lshl_add_u32 v142, v39, 13, v38
    v_lshl_add_u32 v35, v39, 10, v38
    v_mul_u32_u24 v128, 3584, v39
    v_add_u32 v128, v128, v38
    s_lshr_b32 s64, s5, 3
    s_and_b32 s65, s5, 7
    s_lshl_b32 s61, s64, 20
    s_lshl_b32 s60, s3, 18
    s_add_u32 s61, s61, s60
    s_lshl_b32 s60, s4, 10
    s_add_u32 s61, s61, s60
    s_lshl_b32 s60, s65, 7
    s_add_u32 s61, s61, s60
    s_lshl_b32 s69, s3, 12
    v_lshlrev_b32 v149, 4, v0
    v_lshlrev_b32 v38, 2, v36
    v_xor_b32 v38, v38, v37
    v_lshlrev_b32 v38, 4, v38
    v_lshl_add_u32 v2, v36, 8, v38
    v_xor_b32 v3, 16, v2
    v_xor_b32 v4, 32, v2
    v_xor_b32 v5, 48, v2
    s_lshl_b32 s63, s3, 1
    s_xor_b32 s63, s63, s5
    s_lshl_b32 s66, s4, 23
    s_lshl_b32 s60, s63, 12
    s_add_u32 s66, s66, s60
    s_lshl_b32 s60, s3, 10
    s_add_u32 s66, s66, s60
    s_add_u32 s66, s66, 0x700000
    s_lshl_b32 s67, s3, 13
    s_add_u32 m0, s60, 65536
    s_cmp_eq_u32 s3, 0
    s_cselect_b32 s62, 0, 0x40000000
    s_waitcnt lgkmcnt(0)
    buffer_load_dwordx4 v149, s[8:11], s62 offen lds
    s_add_u32 m0, s69, 32768
    s_nop 0
    buffer_load_dwordx4 v142, s[20:23], s61 offen nt lds
    s_add_u32 m0, s69, 33792
    s_add_u32 s61, s61, 65536
    buffer_load_dwordx4 v142, s[20:23], s61 offen nt lds
    s_add_u32 m0, s69, 34816
    s_add_u32 s61, s61, 65536
    buffer_load_dwordx4 v142, s[20:23], s61 offen nt lds
    s_add_u32 m0, s69, 35840
    s_add_u32 s61, s61, 65536
    buffer_load_dwordx4 v142, s[20:23], s61 offen nt lds
    s_add_u32 m0, s67, 0
    s_xor_b32 s60, s66, 0x0
    buffer_load_dwordx4 v2, s[12:15], s60 offen nt lds
    s_add_u32 m0, s67, 1024
    s_xor_b32 s60, s66, 0x21000
    buffer_load_dwordx4 v3, s[12:15], s60 offen nt lds
    s_add_u32 m0, s67, 2048
    s_xor_b32 s60, s66, 0x42000
    buffer_load_dwordx4 v4, s[12:15], s60 offen nt lds
    s_add_u32 m0, s67, 3072
    s_xor_b32 s60, s66, 0x63000
    buffer_load_dwordx4 v5, s[12:15], s60 offen nt lds
    s_load_dword s48, s[44:45], 0
    s_load_dwordx2 s[24:25], s[0:1], 32
    s_load_dwordx2 s[28:29], s[0:1], 48
    s_load_dwordx2 s[32:33], s[0:1], 56
    s_load_dwordx2 s[36:37], s[0:1], 64
    s_load_dwordx2 s[40:41], s[0:1], 72
    s_branch L_A2
L_T:
    s_cmp_lg_u32 s3, 5
    s_cbranch_scc1 L_tc5_5
    s_call_b64 s[70:71], L_pad_a2
L_tc5_5:
    s_cmp_lg_u32 s3, 6
    s_cbranch_scc1 L_tc5_6
    s_call_b64 s[70:71], L_pad_a4
L_tc5_6:
    s_cmp_lg_u32 s3, 7
    s_cbranch_scc1 L_tc5_7
    s_call_b64 s[70:71], L_pad_a5
L_tc5_7:
    s_cmp_lg_u32 s3, 8
    s_cbranch_scc1 L_tc5_8
    s_call_b64 s[70:71], L_pad_tail
L_tc5_8:
    s_endpgm
L_A2:
    s_mov_b32 s26, 0x400000
    s_mov_b32 s27, 0x20000
    s_mov_b32 s30, 0x1c0000
    s_mov_b32 s31, 0x20000
    s_mov_b32 s34, 0x1c0000
    s_mov_b32 s35, 0x20000
    s_mov_b32 s38, 0x1c0000
    s_mov_b32 s39, 0x20000
    s_mov_b32 s42, 0x400
    s_mov_b32 s43, 0x20000
    s_and_b32 s58, s5, 7
    s_lshr_b32 s60, s5, 3
    s_lshl_b32 s61, s4, 2
    s_mul_i32 s62, s4, 3
    s_add_u32 s62, s62, 4
    s_cmp_lt_u32 s4, 4
    s_cselect_b32 s61, s61, s62
    s_cselect_b32 s63, 4, 3
    s_add_u32 s57, s61, s60
    s_cmp_lt_u32 s60, s63
    s_cselect_b32 s59, 1, 0
    v_lshlrev_b32 v39, 4, v37
    v_lshl_add_u32 v6, v36, 10, v39
    v_add_u32 v152, 0x1000, v6
    v_xor_b32 v38, v36, v37
    v_lshlrev_b32 v38, 4, v38
    v_and_b32 v39, 3, v0
    v_lshl_add_u32 v8, v39, 10, v38
    v_lshrrev_b32 v39, 2, v37
    v_lshl_add_u32 v8, v39, 8, v8
    v_add_u32 v8, s67, v8
    v_xor_b32 v9, 64, v8
    v_xor_b32 v10, 0x80, v8
    v_xor_b32 v11, 0xc0, v8
    s_lshl_b32 s62, s58, 6
    s_lshl_b32 s63, s3, 4
    s_add_u32 s62, s62, s63
    v_and_b32 v38, 3, v0
    v_lshl_add_u32 v38, v38, 2, v36
    v_add_u32 v28, s62, v38
    v_lshlrev_b32 v28, 1, v28
    v_add_u32 v30, s63, v38
    v_lshlrev_b32 v30, 1, v30
    v_add_u32 v30, 77824, v30
    v_add_u32 v158, s63, v37
    v_lshlrev_b32 v158, 1, v158
    v_add_u32 v158, 78080, v158
    v_lshlrev_b32 v159, 3, v36
    v_add_u32 v159, 78080, v159
    s_add_u32 s63, s63, 76032
    v_mov_b32 v154, s63
    v_lshrrev_b32 v38, 2, v37
    v_mul_u32_u24 v12, 320, v38
    v_lshl_add_u32 v12, v36, 4, v12
    v_add_u32 v12, 74752, v12
    s_lshl_b32 s60, s3, 2
    s_add_u32 s60, s60, 76032
    v_lshlrev_b32 v13, 4, v38
    v_add_u32 v13, s60, v13
    s_lshl_b32 s60, s3, 11
    s_add_u32 s60, s60, 0
    v_add_u32 v14, s60, v149
    s_lshl_b32 s60, s3, 8
    s_add_u32 s60, s60, 0
    v_bfe_u32 v38, v0, 2, 1
    v_lshlrev_b32 v15, 10, v38
    v_lshl_add_u32 v15, v36, 6, v15
    v_bfe_u32 v38, v0, 1, 1
    v_lshl_add_u32 v15, v38, 5, v15
    v_bfe_u32 v38, v0, 3, 1
    v_lshl_add_u32 v15, v38, 4, v15
    v_and_b32 v39, 1, v0
    v_lshl_add_u32 v15, v39, 3, v15
    v_add_u32 v15, s60, v15
    v_lshlrev_b32 v16, 2, v0
    v_lshlrev_b32 v17, 4, v37
    v_lshl_add_u32 v17, v36, 9, v17
    v_add_u32 v150, 256, v17
    v_lshrrev_b32 v161, 2, v0
    v_lshlrev_b32 v161, 9, v161
    v_and_b32 v39, 3, v0
    v_lshl_add_u32 v161, v39, 2, v161
    v_and_b32 v39, 31, v0
    v_lshlrev_b32 v18, 4, v39
    s_lshl_b32 s60, s3, 7
    s_add_u32 s60, s60, 76288
    v_lshlrev_b32 v19, 2, v39
    v_add_u32 v19, s60, v19
    v_lshlrev_b32 v20, 4, v36
    v_add_u32 v20, s60, v20
    s_lshl_b32 s60, s3, 8
    s_add_u32 s60, s60, 76800
    v_add_u32 v21, s60, v16
    v_lshrrev_b32 v38, 2, v0
    v_lshlrev_b32 v27, 8, v38
    v_and_b32 v39, 3, v0
    v_lshl_add_u32 v27, v39, 4, v27
    v_add_u32 v151, 0x1000, v27
    v_lshlrev_b32 v38, 7, v38
    v_lshl_add_u32 v38, v39, 3, v38
    v_bfe_u32 v39, v0, 3, 2
    v_lshl_add_u32 v38, v39, 5, v38
    s_lshl_b32 s60, s3, 5
    v_xor_b32 v26, s60, v38
    v_add_u32 v26, 32768, v26
    v_add_u32 v22, s69, v38
    v_add_u32 v22, 32768, v22
    v_xor_b32 v23, 32, v22
    v_xor_b32 v24, 64, v22
    v_xor_b32 v25, 0x60, v22
    v_cmp_eq_u32 vcc, 1, v37
    v_mov_b32 v38, 77824
    v_mov_b32 v39, 77952
    v_cndmask_b32 v31, v38, v39, vcc
    v_lshl_add_u32 v31, v36, 3, v31
    v_cmp_gt_u32 vcc, 16, v0
    v_mov_b32 v38, 0x80000000
    v_lshlrev_b32 v39, 2, v36
    v_cndmask_b32 v32, v38, v149, vcc
    v_cmp_eq_u32 vcc, 0, v37
    s_lshl_b32 s60, s64, 8
    s_add_u32 s60, s60, 73728
    v_cndmask_b32 v131, v38, v0, vcc
    v_cmp_eq_u32 vcc, 0, v0
    v_lshlrev_b32 v143, 3, v36
    v_add_u32 v143, s60, v143
    v_cndmask_b32 v148, v38, 0, vcc
    v_lshlrev_b32 v166, 2, v37
    v_lshl_add_u32 v166, v36, 7, v166
    v_and_b32 v39, 3, v0
    v_cmp_eq_u32 vcc, 0, v39
    v_lshlrev_b32 v39, 5, v0
    v_add_u32 v39, 0x200, v39
    v_cndmask_b32 v153, v38, v39, vcc
    v_cmp_gt_u32 vcc, 48, v0
    v_and_b32 v157, 7, v0
    v_lshlrev_b32 v157, 4, v157
    v_cndmask_b32 v160, v38, v151, vcc
    v_cmp_gt_u32 vcc, 8, v0
    s_cmp_eq_u32 s3, 0
    s_cselect_b64 vcc, vcc, 0
    s_cmp_le_u32 s64, 0
    s_cselect_b64 vcc, vcc, 0
    v_lshlrev_b32 v39, 12, v0
    v_cndmask_b32 v155, v38, v39, vcc
    v_and_b32 v38, 1, v0
    v_cmp_eq_u32 vcc, 1, v38
    v_mov_b32 v38, 0xffff
    v_mov_b32 v39, 0xffff0000
    v_cndmask_b32 v38, v38, v39, vcc
    v_and_b32 v39, 2, v0
    v_cmp_eq_u32 vcc, 0, v39
    s_mov_b32 s73, 0xffffff00
    v_lshrrev_b32 v39, 5, v0
    v_cndmask_b32 v33, 0, v38, vcc
    v_cndmask_b32 v34, v38, 0, vcc
    v_lshlrev_b32 v129, 12, v39
    v_and_b32 v38, 31, v0
    v_lshl_add_u32 v129, v38, 4, v129
    v_lshlrev_b32 v130, 2, v39
    v_lshl_add_u32 v130, v38, 3, v130
    s_mul_i32 s60, s3, 320
    s_add_u32 s60, s60, 74752
    v_add_u32 v130, s60, v130
    v_add_u32 v132, 65536, v28
    s_mov_b32 s49, 0x3db504f3
    s_mov_b32 s50, 0x3fb8aa3b
    s_branch L_ps_a2
L_pad_a2:
    s_setpc_b64 s[70:71]
L_ps_a2:
    s_waitcnt vmcnt(8)
    s_barrier
    ds_read_u16 v29, v132
    s_lshl_b32 s23, s4, 2
    s_add_u32 s23, s23, s64
    s_lshl_b32 s68, s23, 17
    s_lshl_b32 s60, s3, 15
    s_add_u32 s68, s68, s60
    s_lshl_b32 s60, s65, 7
    s_add_u32 s68, s68, s60
    s_lshl_b32 s80, s4, 13
    s_lshl_b32 s60, s5, 8
    s_add_u32 s80, s80, s60
    s_lshl_b32 s60, s3, 6
    s_add_u32 s80, s80, s60
    s_add_u32 s80, s80, 0x1000
    s_lshl_b32 s79, s4, 13
    s_lshl_b32 s60, s3, 9
    s_add_u32 s79, s79, s60
    s_add_u32 s79, s79, 0x1000
    s_lshl_b32 s61, s58, 2
    s_add_u32 s61, s61, s3
    s_mul_i32 s76, s61, 57344
    s_lshl_b32 s61, s57, 7
    s_add_u32 s76, s76, s61
    s_lshl_b32 s77, s57, 16
    s_lshl_b32 s60, s3, 14
    s_add_u32 s77, s77, s60
    s_lshl_b32 s60, s58, 7
    s_add_u32 s77, s77, s60
    s_cmp_eq_u32 s59, 0
    s_cselect_b32 s76, 0x40000000, s76
    s_cselect_b32 s77, 0x40000000, s77
    s_lshl_b32 s78, s3, 11
    s_lshl_b32 s81, s4, 15
    s_lshl_b32 s60, s3, 13
    s_add_u32 s81, s81, s60
    s_lshl_b32 s60, s5, 4
    s_add_u32 s81, s81, s60
    s_add_u32 s81, s81, 0x80000
    s_lshl_b32 s61, s4, 2
    s_add_u32 s61, s61, s3
    s_mul_i32 s82, s61, 3072
    s_add_u32 s82, s82, 0xe0000
    s_lshl_b32 s61, s5, 2
    s_add_u32 s71, s82, s61
    s_lshl_b32 s61, s5, 4
    s_add_u32 s82, s82, s61
    s_lshl_b32 s83, s23, 13
    s_lshl_b32 s60, s3, 11
    s_add_u32 s83, s83, s60
    s_add_u32 s83, s83, 0x80000
    s_mul_i32 s84, s23, 3072
    s_add_u32 s84, s84, 0xe0000
    s_lshr_b32 s61, s23, 3
    s_and_b32 s62, s23, 7
    s_lshl_b32 s85, s65, 9
    s_lshl_b32 s60, s4, 2
    s_add_u32 s85, s85, s60
    s_add_u32 s85, s85, 0xd0000
    s_lshl_b32 s21, s58, 13
    s_lshl_b32 s60, s3, 6
    s_add_u32 s21, s21, s60
    s_add_u32 s21, s21, 0x62000
    s_lshl_b32 s8, s4, 16
    s_lshl_b32 s60, s58, 13
    s_add_u32 s8, s8, s60
    s_lshl_b32 s60, s3, 6
    s_add_u32 s8, s8, s60
    s_add_u32 s8, s8, 0x100000
    s_lshl_b32 s10, s57, 13
    s_lshl_b32 s60, s3, 8
    s_add_u32 s10, s10, s60
    s_add_u32 s10, s10, 0x28000
    s_lshl_b32 s9, s57, 13
    s_lshl_b32 s60, s58, 10
    s_add_u32 s9, s9, s60
    s_lshl_b32 s60, s3, 8
    s_add_u32 s9, s9, s60
    s_add_u32 s9, s9, 0x28000
    s_lshl_b32 s11, s57, 7
    s_add_u32 s11, s11, 0x60000
    s_lshl_b32 s20, s58, 13
    s_lshl_b32 s60, s57, 8
    s_add_u32 s20, s20, s60
    s_lshl_b32 s60, s3, 6
    s_add_u32 s20, s20, s60
    s_add_u32 s20, s20, 0x62000
    s_lshr_b32 s61, s57, 3
    s_and_b32 s62, s57, 7
    s_lshl_b32 s22, s58, 9
    s_lshl_b32 s60, s61, 7
    s_add_u32 s22, s22, s60
    s_lshl_b32 s60, s62, 2
    s_add_u32 s22, s22, s60
    s_add_u32 s22, s22, 0x26000
    s_cmp_eq_u32 s3, 0
    s_cselect_b32 s22, s22, 0x40000000
    s_lshl_b32 s23, s3, 9
    s_add_u32 s23, s23, s84
    s_waitcnt lgkmcnt(0)
    s_andn2_b32 s48, s48, 0xff
    s_mul_i32 s48, s48, 0x9e3779b1
    s_add_u32 s48, s48, 0x7f4a7d15
    s_bfe_u32 s60, s48, 0x80008
    s_lshr_b32 s61, s48, 24
    s_cmp_eq_u32 s60, s61
    s_cselect_b32 s60, 0x200, 0
    s_xor_b32 s48, s48, s60
    s_and_b32 s52, s48, 0xff
    s_bfe_u32 s53, s48, 0x80008
    s_bfe_u32 s54, s48, 0x80010
    s_lshr_b32 s55, s48, 24
    s_getreg_b32 s60, hwreg(HW_REG_XCC_ID, 0, 4)
    s_and_b32 s75, s52, 0xf0
    s_or_b32 s75, s75, s60
    v_mov_b32 v36, s75
    v_mov_b32 v162, s52
    v_mov_b32 v163, s53
    v_mov_b32 v164, s54
    v_mov_b32 v165, s55
    v_mov_b32 v156, s48
    v_mov_b32 v146, s48
    v_mov_b32 v147, s48
    s_waitcnt vmcnt(4)
    s_barrier
    ds_read2_b64 v[104:107], v143 offset0:0 offset1:4
    ds_read_b64_tr_b16 v[72:73], v26 offset:0
    ds_read_b64_tr_b16 v[74:75], v26 offset:2048
    ds_read2_b64 v[108:111], v143 offset0:8 offset1:12
    ds_read_b64_tr_b16 v[76:77], v26 offset:4096
    ds_read_b64_tr_b16 v[78:79], v26 offset:6144
    ds_read2_b64 v[112:115], v143 offset0:16 offset1:20
    ds_read_b64_tr_b16 v[80:81], v26 offset:8192
    ds_read_b64_tr_b16 v[82:83], v26 offset:10240
    ds_read2_b64 v[116:119], v143 offset0:24 offset1:28
    ds_read_b64_tr_b16 v[84:85], v26 offset:12288
    ds_read_b64_tr_b16 v[86:87], v26 offset:14336
    s_waitcnt lgkmcnt(9)
    v_mfma_f32_16x16x32_bf16 v[120:123], v[72:75], v[104:107], 0
    s_waitcnt lgkmcnt(6)
    v_mfma_f32_16x16x32_bf16 v[120:123], v[76:79], v[108:111], v[120:123]
    s_waitcnt lgkmcnt(3)
    v_mfma_f32_16x16x32_bf16 v[120:123], v[80:83], v[112:115], v[120:123]
    s_waitcnt lgkmcnt(0)
    v_mfma_f32_16x16x32_bf16 v[120:123], v[84:87], v[116:119], v[120:123]
    v_add_u32 v26, 16384, v26
    v_lshlrev_b32 v29, 16, v29
    s_nop 5
    v_and_or_b32 v124, v120, s73, v36
    v_and_or_b32 v125, v121, s73, v163
    v_and_or_b32 v126, v122, s73, v164
    v_and_or_b32 v127, v123, s73, v165
    buffer_store_dwordx4 v[124:127], v131, s[44:47], s80 offen
    s_add_u32 s80, s80, 0xbf000
    buffer_store_dwordx4 v[124:127], v131, s[44:47], s80 offen sc1
    s_add_u32 m0, s67, 4096
    s_xor_b32 s60, s66, 0x84000
    buffer_load_dwordx4 v2, s[12:15], s60 offen nt lds
    s_add_u32 m0, s67, 5120
    s_xor_b32 s60, s66, 0xa5000
    buffer_load_dwordx4 v3, s[12:15], s60 offen nt lds
    s_add_u32 m0, s67, 6144
    s_xor_b32 s60, s66, 0xc6000
    buffer_load_dwordx4 v4, s[12:15], s60 offen nt lds
    s_add_u32 m0, s67, 7168
    s_xor_b32 s60, s66, 0xe7000
    buffer_load_dwordx4 v5, s[12:15], s60 offen nt lds
    s_xor_b32 s60, s66, 0x0
    buffer_load_dwordx4 v[40:43], v149, s[16:19], s60 offen nt
    s_xor_b32 s60, s66, 0x21000
    buffer_load_dwordx4 v[44:47], v149, s[16:19], s60 offen nt
    s_waitcnt vmcnt(3)
    s_barrier
    buffer_load_dwordx4 v[132:135], v129, s[44:47], s79 offen sc1
    buffer_load_dwordx4 v[136:139], v129, s[44:47], s79 offen offset:2048 sc1
    s_barrier
    s_xor_b32 s60, s66, 0x42000
    buffer_load_dwordx4 v[48:51], v149, s[16:19], s60 offen nt
    s_xor_b32 s60, s66, 0x63000
    buffer_load_dwordx4 v[52:55], v149, s[16:19], s60 offen nt
    s_xor_b32 s60, s66, 0x84000
    buffer_load_dwordx4 v[56:59], v149, s[16:19], s60 offen nt
    s_xor_b32 s60, s66, 0xa5000
    buffer_load_dwordx4 v[60:63], v149, s[16:19], s60 offen nt
    s_xor_b32 s60, s66, 0xc6000
    buffer_load_dwordx4 v[64:67], v149, s[16:19], s60 offen nt
    s_xor_b32 s60, s66, 0xe7000
    buffer_load_dwordx4 v[68:71], v149, s[16:19], s60 offen nt
    s_lshl_b32 s60, s3, 2
    s_add_u32 s60, s60, 76160
    v_mov_b32 v38, s60
    v_mov_b32 v39, 76160
    s_branch L_ps_a4
    .p2align 12
L_pad_a4:
    s_setpc_b64 s[70:71]
L_ps_a4:
    s_waitcnt vmcnt(10)
    ds_read_b128 v[72:75], v8 offset:0
    ds_read_b128 v[76:79], v9 offset:0
    ds_read_b128 v[80:83], v10 offset:0
    ds_read_b128 v[84:87], v11 offset:0
    ds_read_b128 v[88:91], v8 offset:4096
    ds_read_b128 v[92:95], v9 offset:4096
    ds_read_b128 v[96:99], v10 offset:4096
    ds_read_b128 v[100:103], v11 offset:4096
    s_waitcnt vmcnt(6)
    v_xor_b32 v132, s75, v132
    v_xor_b32 v136, s75, v136
    v_xor_b32 v133, s53, v133
    v_xor_b32 v137, s53, v137
    v_xor_b32 v134, s54, v134
    v_xor_b32 v138, s54, v138
    v_xor_b32 v135, s55, v135
    v_xor_b32 v139, s55, v139
    v_or_b32 v140, v132, v136
    v_or3_b32 v141, v133, v134, v135
    v_and_b32 v132, s73, v132
    v_and_b32 v136, s73, v136
    v_or3_b32 v141, v141, v137, v138
    v_and_b32 v36, 0xf0, v140
    v_or3_b32 v141, v141, v139, v36
    v_pk_add_f32 v[132:133], v[132:133], v[136:137]
    v_pk_add_f32 v[134:135], v[134:135], v[138:139]
    v_and_b32 v141, 0xff, v141
    v_cmp_ne_u32 vcc, 0, v141
    s_cbranch_vccnz L_h1_retry
L_h1_done:
    v_permlane32_swap_b32 v132, v134
    v_permlane32_swap_b32 v133, v135
    v_and_b32 v140, 15, v140
    v_pk_add_f32 v[132:133], v[132:133], v[134:135]
    v_cmp_ne_u32 vcc, 0, v140
    v_cvt_pk_bf16_f32 v132, v132, v133
    s_cmp_eq_u64 vcc, 0
    ds_write_b32 v130, v132
    s_cselect_b32 s61, 1, 0
    v_mov_b32 v37, s61
    ds_write_b32 v38, v37
    s_waitcnt lgkmcnt(0)
    s_barrier
    ds_read_b128 v[104:107], v12 offset:0
    ds_read_b128 v[108:111], v12 offset:64
    ds_read_b128 v[112:115], v12 offset:128
    ds_read_b128 v[116:119], v12 offset:192
    ds_read_b128 v[132:135], v39
    s_add_u32 m0, s69, 32768
    s_add_u32 s60, s68, 0
    buffer_load_dwordx4 v35, s[24:27], s60 offen nt lds
    s_add_u32 m0, s69, 33792
    s_add_u32 s60, s68, 8192
    buffer_load_dwordx4 v35, s[24:27], s60 offen nt lds
    s_add_u32 m0, s69, 34816
    s_add_u32 s60, s68, 16384
    buffer_load_dwordx4 v35, s[24:27], s60 offen nt lds
    s_add_u32 m0, s69, 35840
    s_add_u32 s60, s68, 24576
    buffer_load_dwordx4 v35, s[24:27], s60 offen nt lds
    s_waitcnt lgkmcnt(4)
    v_mfma_f32_16x16x32_bf16 v[120:123], v[72:75], v[104:107], 0
    v_mfma_f32_16x16x32_bf16 v[124:127], v[88:91], v[104:107], 0
    s_waitcnt lgkmcnt(3)
    v_mfma_f32_16x16x32_bf16 v[120:123], v[76:79], v[108:111], v[120:123]
    v_mfma_f32_16x16x32_bf16 v[124:127], v[92:95], v[108:111], v[124:127]
    s_waitcnt lgkmcnt(2)
    v_mfma_f32_16x16x32_bf16 v[120:123], v[80:83], v[112:115], v[120:123]
    v_mfma_f32_16x16x32_bf16 v[124:127], v[96:99], v[112:115], v[124:127]
    s_waitcnt lgkmcnt(1)
    v_mfma_f32_16x16x32_bf16 v[120:123], v[84:87], v[116:119], v[120:123]
    v_mfma_f32_16x16x32_bf16 v[124:127], v[100:103], v[116:119], v[124:127]
    s_waitcnt lgkmcnt(0)
    v_and_b32 v132, v132, v133
    v_and_b32 v134, v134, v135
    v_and_b32 v132, v132, v134
    v_mov_b32 v38, s49
    v_mov_b32 v39, s49
    v_readfirstlane_b32 s56, v132
    v_cvt_pk_bf16_f32 v120, 0, v120
    v_cvt_pk_bf16_f32 v121, 0, v121
    v_cvt_pk_bf16_f32 v122, 0, v122
    v_cvt_pk_bf16_f32 v123, 0, v123
    v_pk_mul_f32 v[120:121], v[120:121], v[38:39]
    v_pk_mul_f32 v[122:123], v[122:123], v[38:39]
    v_cvt_pk_bf16_f32 v120, 0, v120
    v_cvt_pk_bf16_f32 v121, 0, v121
    v_cvt_pk_bf16_f32 v122, 0, v122
    v_cvt_pk_bf16_f32 v123, 0, v123
    v_cvt_pk_bf16_f32 v124, 0, v124
    v_cvt_pk_bf16_f32 v125, 0, v125
    v_cvt_pk_bf16_f32 v126, 0, v126
    v_cvt_pk_bf16_f32 v127, 0, v127
    v_pk_mul_f32 v[124:125], v[124:125], v[38:39]
    v_pk_mul_f32 v[126:127], v[126:127], v[38:39]
    v_cvt_pk_bf16_f32 v124, 0, v124
    v_cvt_pk_bf16_f32 v125, 0, v125
    v_cvt_pk_bf16_f32 v126, 0, v126
    v_cvt_pk_bf16_f32 v127, 0, v127
    v_max3_f32 v36, v120, v121, v122
    v_max3_f32 v37, v123, v124, v125
    v_max3_f32 v36, v36, v126, v127
    v_max_f32 v36, v36, v37
    v_mov_b32 v37, v36
    s_cmp_eq_u32 s56, 0
    s_nop 0
    v_permlane16_swap_b32 v36, v37
    v_max_f32 v36, v36, v37
    v_mov_b32 v37, v36
    s_nop 1
    v_permlane32_swap_b32 v36, v37
    v_max_f32 v36, v36, v37
    ds_write_b32 v13, v36
    v_mul_f32 v36, s50, v36
    v_fma_f32 v120, v120, s50, -v36
    v_exp_f32 v120, v120
    v_fma_f32 v121, v121, s50, -v36
    v_exp_f32 v121, v121
    v_fma_f32 v122, v122, s50, -v36
    v_exp_f32 v122, v122
    v_fma_f32 v123, v123, s50, -v36
    v_exp_f32 v123, v123
    v_fma_f32 v124, v124, s50, -v36
    v_exp_f32 v124, v124
    v_fma_f32 v125, v125, s50, -v36
    v_exp_f32 v125, v125
    v_fma_f32 v126, v126, s50, -v36
    v_exp_f32 v126, v126
    v_fma_f32 v127, v127, s50, -v36
    v_exp_f32 v127, v127
    v_cvt_pk_bf16_f32 v38, v120, v120
    v_and_b32 v72, v38, v33
    v_and_b32 v73, v38, v34
    v_cvt_pk_bf16_f32 v38, v121, v121
    v_and_b32 v74, v38, v33
    v_and_b32 v75, v38, v34
    s_waitcnt vmcnt(13)
    v_mfma_f32_16x16x16_bf16 v[88:91], v[72:73], v[40:41], 0
    v_mfma_f32_16x16x16_bf16 v[92:95], v[72:73], v[42:43], 0
    v_cvt_pk_bf16_f32 v38, v122, v122
    v_and_b32 v76, v38, v33
    v_and_b32 v77, v38, v34
    s_waitcnt vmcnt(12)
    v_mfma_f32_16x16x16_bf16 v[88:91], v[74:75], v[44:45], v[88:91]
    v_mfma_f32_16x16x16_bf16 v[92:95], v[74:75], v[46:47], v[92:95]
    v_cvt_pk_bf16_f32 v38, v123, v123
    v_and_b32 v78, v38, v33
    v_and_b32 v79, v38, v34
    s_waitcnt vmcnt(9)
    v_mfma_f32_16x16x16_bf16 v[88:91], v[76:77], v[48:49], v[88:91]
    v_mfma_f32_16x16x16_bf16 v[92:95], v[76:77], v[50:51], v[92:95]
    v_cvt_pk_bf16_f32 v38, v124, v124
    v_and_b32 v80, v38, v33
    v_and_b32 v81, v38, v34
    s_waitcnt vmcnt(8)
    v_mfma_f32_16x16x16_bf16 v[88:91], v[78:79], v[52:53], v[88:91]
    v_mfma_f32_16x16x16_bf16 v[92:95], v[78:79], v[54:55], v[92:95]
    v_cvt_pk_bf16_f32 v38, v125, v125
    v_and_b32 v82, v38, v33
    v_and_b32 v83, v38, v34
    v_cvt_pk_bf16_f32 v38, v126, v126
    v_and_b32 v84, v38, v33
    v_and_b32 v85, v38, v34
    v_cvt_pk_bf16_f32 v38, v127, v127
    v_and_b32 v86, v38, v33
    v_and_b32 v87, v38, v34
    v_pk_add_f32 v[120:121], v[120:121], v[122:123]
    v_pk_add_f32 v[124:125], v[124:125], v[126:127]
    s_waitcnt vmcnt(7)
    v_mfma_f32_16x16x16_bf16 v[88:91], v[80:81], v[56:57], v[88:91]
    v_mfma_f32_16x16x16_bf16 v[92:95], v[80:81], v[58:59], v[92:95]
    v_pk_add_f32 v[120:121], v[120:121], v[124:125]
    v_add_f32 v36, v120, v121
    v_mov_b32 v37, v36
    s_nop 1
    v_permlane16_swap_b32 v36, v37
    v_add_f32 v36, v36, v37
    v_mov_b32 v37, v36
    s_nop 1
    v_permlane32_swap_b32 v36, v37
    v_add_f32 v36, v36, v37
    ds_write_b32 v13, v36 offset:64
    s_branch L_ps_a5
L_pad_a5:
    s_setpc_b64 s[70:71]
L_ps_a5:
    s_waitcnt lgkmcnt(0)
    s_barrier
    ds_read_b128 v[104:107], v154
    ds_read_b128 v[108:111], v154 offset:64
    s_waitcnt vmcnt(6)
    v_mfma_f32_16x16x16_bf16 v[88:91], v[82:83], v[60:61], v[88:91]
    v_mfma_f32_16x16x16_bf16 v[92:95], v[82:83], v[62:63], v[92:95]
    s_waitcnt lgkmcnt(1)
    v_max3_f32 v144, v104, v105, v106
    v_max_f32 v144, v144, v107
    v_mul_f32 v36, s50, v144
    v_fma_f32 v104, v104, s50, -v36
    v_exp_f32 v104, v104
    v_fma_f32 v105, v105, s50, -v36
    v_exp_f32 v105, v105
    v_fma_f32 v106, v106, s50, -v36
    v_exp_f32 v106, v106
    v_fma_f32 v107, v107, s50, -v36
    v_exp_f32 v107, v107
    s_waitcnt lgkmcnt(0)
    v_pk_mul_f32 v[108:109], v[108:109], v[104:105]
    v_pk_fma_f32 v[108:109], v[110:111], v[106:107], v[108:109]
    v_add_f32 v145, v108, v109
    s_waitcnt vmcnt(5)
    v_mfma_f32_16x16x16_bf16 v[88:91], v[84:85], v[64:65], v[88:91]
    v_mfma_f32_16x16x16_bf16 v[92:95], v[84:85], v[66:67], v[92:95]
    s_waitcnt vmcnt(4)
    v_mfma_f32_16x16x16_bf16 v[88:91], v[86:87], v[68:69], v[88:91]
    v_mfma_f32_16x16x16_bf16 v[92:95], v[86:87], v[70:71], v[92:95]
    s_nop 6
    ds_write_b128 v14, v[88:91]
    ds_write_b128 v14, v[92:95] offset:1024
    s_waitcnt lgkmcnt(0)
    s_barrier
    ds_read_b64 v[112:113], v15 offset:0
    ds_read_b64 v[114:115], v15 offset:2048
    ds_read_b64 v[116:117], v15 offset:4096
    ds_read_b64 v[118:119], v15 offset:6144
    s_waitcnt lgkmcnt(3)
    v_pk_mul_f32 v[112:113], v[112:113], v[104:105] op_sel:[0,0] op_sel_hi:[1,0]
    s_waitcnt lgkmcnt(2)
    v_pk_fma_f32 v[112:113], v[114:115], v[104:105], v[112:113] op_sel:[0,1,0] op_sel_hi:[1,1,1]
    s_waitcnt lgkmcnt(1)
    v_pk_fma_f32 v[112:113], v[116:117], v[106:107], v[112:113] op_sel:[0,0,0] op_sel_hi:[1,0,1]
    s_waitcnt lgkmcnt(0)
    v_pk_fma_f32 v[112:113], v[118:119], v[106:107], v[112:113] op_sel:[0,1,0] op_sel_hi:[1,1,1]
    v_cvt_pk_bf16_f32 v36, v112, v113
    s_cbranch_scc1 L_slow0
    buffer_store_dword v36, v161, s[44:47], s81 offen
L_back0:
    v_xor_b32_dpp v37, v36, v36 quad_perm:[1,0,3,2] row_mask:0xf bank_mask:0xf
    v_xor_b32 v38, s48, v37
    s_nop 1
    v_xor_b32_dpp v37, v37, v38 quad_perm:[2,3,0,1] row_mask:0xf bank_mask:0xf
    s_cbranch_scc1 L_slow1
    buffer_store_dword v37, v153, s[44:47], s71 offen
L_back1:
    s_cbranch_scc1 L_slow2
    buffer_store_dwordx4 v[144:147], v148, s[44:47], s82 offen
L_back2:
    s_mov_b64 s[62:63], -1
    s_mov_b64 s[64:65], -1
    s_mov_b32 s72, 1000000
    buffer_load_dwordx4 v[48:51], v18, s[44:47], s84 offen sc1
    s_waitcnt vmcnt(0)
    v_xor_b32 v69, s48, v50
    v_bitop3_b32 v69, v51, s48, v69 bitop3:0xbe
    v_cmp_ne_u32 vcc, 0, v69
    ds_read_b64_tr_b16 v[72:73], v22 offset:0
    ds_read_b64_tr_b16 v[74:75], v22 offset:2048
    ds_read_b64_tr_b16 v[76:77], v23 offset:0
    ds_read_b64_tr_b16 v[78:79], v23 offset:2048
    ds_read_b64_tr_b16 v[80:81], v24 offset:0
    ds_read_b64_tr_b16 v[82:83], v24 offset:2048
    ds_read_b64_tr_b16 v[84:85], v25 offset:0
    ds_read_b64_tr_b16 v[86:87], v25 offset:2048
    s_cbranch_vccz L_h2m_done
L_h2m:
    s_sub_u32 s72, s72, 1
    s_cbranch_scc1 L_h2m_done
    buffer_load_dwordx4 v[48:51], v18, s[44:47], s84 offen sc1
    s_waitcnt vmcnt(0)
    v_xor_b32 v69, s48, v50
    v_bitop3_b32 v69, v51, s48, v69 bitop3:0xbe
    v_cmp_ne_u32 vcc, 0, v69
    s_cbranch_vccnz L_h2m
L_h2m_done:
    s_mov_b64 exec, s[62:63]
    buffer_load_dwordx4 v[40:43], v17, s[44:47], s83 offen sc1
    buffer_load_dword v52, v166, s[44:47], s23 offen offset:512 sc1
    s_mov_b64 exec, s[64:65]
    buffer_load_dwordx4 v[44:47], v150, s[44:47], s83 offen sc1
    buffer_load_dword v53, v166, s[44:47], s23 offen offset:576 sc1
    s_mov_b64 exec, -1
    v_mov_b32 v36, v48
    s_barrier
    s_nop 0
    v_max_f32_dpp v36, v36, v36 row_ror:8 row_mask:0xf bank_mask:0xf
    s_nop 1
    v_max_f32_dpp v36, v36, v36 row_ror:4 row_mask:0xf bank_mask:0xf
    s_nop 1
    v_max_f32_dpp v36, v36, v36 row_ror:2 row_mask:0xf bank_mask:0xf
    s_nop 1
    v_max_f32_dpp v36, v36, v36 row_ror:1 row_mask:0xf bank_mask:0xf
    v_mov_b32 v37, v36
    s_nop 1
    v_permlane16_swap_b32 v36, v37
    v_max_f32 v36, v36, v37
    v_sub_f32 v36, v48, v36
    v_mul_f32 v36, s50, v36
    v_exp_f32 v36, v36
    s_nop 0
    ds_write_b32 v19, v36
    v_mul_f32 v68, v36, v49
    ds_read_b128 v[120:123], v20
    ds_read_b128 v[124:127], v20 offset:64
    s_waitcnt lgkmcnt(3)
    s_waitcnt vmcnt(3)
    v_mfma_f32_16x16x32_bf16 v[88:91], v[40:43], v[72:75], 0
    v_add_f32_dpp v68, v68, v68 row_ror:8 row_mask:0xf bank_mask:0xf
    v_mfma_f32_16x16x32_bf16 v[92:95], v[40:43], v[76:79], 0
    v_bitop3_b32 v36, v40, v41, v42 bitop3:0x96
    v_add_f32_dpp v68, v68, v68 row_ror:4 row_mask:0xf bank_mask:0xf
    v_mfma_f32_16x16x32_bf16 v[96:99], v[40:43], v[80:83], 0
    s_waitcnt vmcnt(2)
    v_add_f32_dpp v68, v68, v68 row_ror:2 row_mask:0xf bank_mask:0xf
    v_mfma_f32_16x16x32_bf16 v[100:103], v[40:43], v[84:87], 0
    v_bitop3_b32 v36, v36, v43, v52 bitop3:0x96
    v_add_f32_dpp v68, v68, v68 row_ror:1 row_mask:0xf bank_mask:0xf
    s_waitcnt vmcnt(1)
    v_mfma_f32_16x16x32_bf16 v[104:107], v[44:47], v[72:75], 0
    v_mov_b32 v38, v68
    v_cmp_ne_u32 s[62:63], s48, v36
    v_mfma_f32_16x16x32_bf16 v[108:111], v[44:47], v[76:79], 0
    v_bitop3_b32 v37, v44, v45, v46 bitop3:0x96
    v_permlane16_swap_b32 v68, v38
    v_mfma_f32_16x16x32_bf16 v[112:115], v[44:47], v[80:83], 0
    v_add_f32 v68, v68, v38
    s_waitcnt lgkmcnt(0)
    v_pk_mul_f32 v[56:57], v[120:121], v[88:89]
    v_mfma_f32_16x16x32_bf16 v[116:119], v[44:47], v[84:87], 0
    v_pk_mul_f32 v[58:59], v[120:121], v[92:93]
    s_waitcnt vmcnt(0)
    v_bitop3_b32 v37, v37, v47, v53 bitop3:0x96
    v_pk_mul_f32 v[60:61], v[120:121], v[96:97]
    v_pk_mul_f32 v[62:63], v[120:121], v[100:101]
    v_cmp_ne_u32 s[64:65], s48, v37
    v_rcp_f32 v68, v68
    v_pk_fma_f32 v[56:57], v[122:123], v[90:91], v[56:57]
    v_pk_fma_f32 v[58:59], v[122:123], v[94:95], v[58:59]
    v_pk_fma_f32 v[60:61], v[122:123], v[98:99], v[60:61]
    v_pk_fma_f32 v[62:63], v[122:123], v[102:103], v[62:63]
    s_or_b64 vcc, s[62:63], s[64:65]
    s_cbranch_scc1 L_h2_retry
L_h2_done:
    v_pk_fma_f32 v[56:57], v[124:125], v[104:105], v[56:57]
    v_pk_fma_f32 v[58:59], v[124:125], v[108:109], v[58:59]
    v_pk_fma_f32 v[60:61], v[124:125], v[112:113], v[60:61]
    v_pk_fma_f32 v[62:63], v[124:125], v[116:117], v[62:63]
    v_pk_fma_f32 v[56:57], v[126:127], v[106:107], v[56:57]
    v_pk_fma_f32 v[58:59], v[126:127], v[110:111], v[58:59]
    v_pk_fma_f32 v[60:61], v[126:127], v[114:115], v[60:61]
    v_pk_fma_f32 v[62:63], v[126:127], v[118:119], v[62:63]
    v_add_f32 v40, v56, v57
    v_add_f32 v41, v58, v59
    v_add_f32 v42, v60, v61
    v_add_f32 v43, v62, v63
    s_nop 1
    v_permlane32_swap_b32 v40, v42
    v_permlane32_swap_b32 v41, v43
    v_add_f32 v40, v40, v42
    v_add_f32 v41, v41, v43
    s_nop 1
    v_permlane16_swap_b32 v40, v41
    v_add_f32 v40, v40, v41
    v_mul_f32 v40, v40, v68
    ds_write_b32 v21, v40
    s_cmp_eq_u32 s59, 0
    s_waitcnt lgkmcnt(0)
    s_barrier
    s_cbranch_scc1 L_exit
    s_barrier
    buffer_load_dwordx4 v[40:43], v27, s[44:47], s8 offen sc1
    buffer_load_dwordx4 v[44:47], v151, s[44:47], s8 offen sc1
    s_barrier
    ds_read_b64_tr_b16 v[48:49], v26 offset:0
    ds_read_b64_tr_b16 v[50:51], v26 offset:2048
    ds_read_b64_tr_b16 v[56:57], v26 offset:8192
    ds_read_b64_tr_b16 v[58:59], v26 offset:10240
    ds_read_b64_tr_b16 v[52:53], v26 offset:4096
    ds_read_b64_tr_b16 v[54:55], v26 offset:6144
    ds_read_b64_tr_b16 v[60:61], v26 offset:12288
    ds_read_b64_tr_b16 v[62:63], v26 offset:14336
    s_waitcnt vmcnt(1)
    v_xor_b32 v40, s52, v40
    v_xor_b32 v41, s53, v41
    v_xor_b32 v42, s54, v42
    v_xor_b32 v43, s55, v43
    v_or3_b32 v69, v40, v41, v42
    s_waitcnt vmcnt(0)
    v_xor_b32 v44, s52, v44
    v_xor_b32 v45, s53, v45
    v_xor_b32 v46, s54, v46
    v_xor_b32 v47, s55, v47
    v_or3_b32 v69, v69, v43, v44
    v_pk_add_f32 v[40:41], v[40:41], v[44:45]
    v_pk_add_f32 v[42:43], v[42:43], v[46:47]
    v_or3_b32 v69, v69, v45, v46
    v_or_b32 v69, v69, v47
    v_permlane32_swap_b32 v40, v42
    v_permlane32_swap_b32 v41, v43
    v_add_f32 v40, v40, v42
    v_add_f32 v41, v41, v43
    v_and_b32 v69, 0xff, v69
    v_cmp_ne_u32 vcc, 0, v69
    v_permlane16_swap_b32 v40, v41
    v_add_f32 v40, v40, v41
    s_nop 1
    v_add_f32_dpp v40, v40, v40 row_ror:8 row_mask:0xf bank_mask:0xf
    s_cbranch_vccnz L_h3_retry
L_h3_done:
    s_nop 0
    v_add_f32_dpp v40, v40, v40 row_ror:4 row_mask:0xf bank_mask:0xf
    v_cvt_pk_bf16_f32 v40, 0, v40
    v_add_f32 v40, v40, v29
    v_cvt_pk_bf16_f32 v7, 0, v40
    ds_write_b16_d16_hi v30, v7
    s_cmp_eq_u32 s56, 0
    s_waitcnt lgkmcnt(0)
    s_barrier
    ds_read2_b64 v[40:43], v31 offset0:0 offset1:4
    ds_read2_b64 v[44:47], v31 offset0:8 offset1:12
    s_waitcnt lgkmcnt(1)
    v_mfma_f32_16x16x32_bf16 v[72:75], v[40:43], v[48:51], 0
    v_mfma_f32_16x16x32_bf16 v[76:79], v[40:43], v[56:59], 0
    s_waitcnt lgkmcnt(0)
    v_mfma_f32_16x16x32_bf16 v[72:75], v[44:47], v[52:55], v[72:75]
    v_mfma_f32_16x16x32_bf16 v[76:79], v[44:47], v[60:63], v[76:79]
    s_nop 6
    v_and_or_b32 v80, v72, s73, v162
    v_and_or_b32 v81, v73, s73, v163
    v_and_or_b32 v82, v76, s73, v164
    v_and_or_b32 v83, v77, s73, v165
    s_cbranch_scc1 L_slow3
    buffer_store_dwordx4 v[80:83], v32, s[44:47], s9 offen
L_back3:
    s_mul_i32 s85, s3, 0
    s_add_u32 s85, s85, 13
    s_barrier
    ds_read_b64_tr_b16 v[56:57], v26 offset:16384
    ds_read_b64_tr_b16 v[58:59], v26 offset:18432
    ds_read_b64_tr_b16 v[60:61], v26 offset:20480
    ds_read_b64_tr_b16 v[62:63], v26 offset:22528
    s_mov_b32 s72, 1000000
L_h35:
    s_sub_u32 s72, s72, 1
    s_cbranch_scc1 L_h35_done
    buffer_load_dwordx4 v[48:51], v157, s[44:47], s11 offen sc1
    buffer_load_dwordx4 v[40:43], v6, s[44:47], s10 offen sc1
    buffer_load_dwordx4 v[44:47], v152, s[44:47], s10 offen sc1
    s_waitcnt vmcnt(2)
    v_xor_b32 v52, s48, v50
    v_add_f32_dpp v48, v48, v48 quad_perm:[1,0,3,2] row_mask:0xf bank_mask:0xf
    v_add_f32_dpp v49, v49, v49 quad_perm:[1,0,3,2] row_mask:0xf bank_mask:0xf
    v_bitop3_b32 v52, v51, s48, v52 bitop3:0xbe
    v_add_f32_dpp v48, v48, v48 quad_perm:[2,3,0,1] row_mask:0xf bank_mask:0xf
    v_add_f32_dpp v49, v49, v49 quad_perm:[2,3,0,1] row_mask:0xf bank_mask:0xf
    v_cmp_ne_u32 vcc, 0, v52
    v_add_f32_dpp v48, v48, v48 row_half_mirror row_mask:0xf bank_mask:0xf
    v_add_f32_dpp v49, v49, v49 row_half_mirror row_mask:0xf bank_mask:0xf
    s_cbranch_vccnz L_h35_w
    v_mul_f32 v48, 0x3b000000, v48
    v_mul_f32 v49, 0x3b000000, v49
    v_fma_f32 v48, -v49, v49, v48
    v_cvt_pk_bf16_f32 v49, 0, v49
    v_max_f32 v48, 0, v48
    v_cvt_pk_bf16_f32 v48, 0, v48
    v_add_f32 v48, 0x3727c5ac, v48
    v_cvt_pk_bf16_f32 v48, 0, v48
    v_sqrt_f32 v48, v48
    s_waitcnt vmcnt(1)
    v_xor_b32 v40, s52, v40
    v_xor_b32 v41, s53, v41
    v_xor_b32 v42, s54, v42
    v_xor_b32 v43, s55, v43
    v_cvt_pk_bf16_f32 v48, 0, v48
    v_or3_b32 v69, v40, v41, v42
    v_rcp_f32 v48, v48
    s_waitcnt vmcnt(0)
    v_xor_b32 v44, s52, v44
    v_xor_b32 v45, s53, v45
    v_xor_b32 v46, s54, v46
    v_xor_b32 v47, s55, v47
    v_or3_b32 v69, v69, v43, v44
    v_pk_add_f32 v[40:41], v[40:41], v[44:45]
    v_pk_add_f32 v[42:43], v[42:43], v[46:47]
    v_or3_b32 v69, v69, v45, v46
    v_fma_f32 v40, -v49, v41, v40
    v_fma_f32 v42, -v49, v43, v42
    v_or_b32 v69, v69, v47
    v_and_b32 v69, 0xff, v69
    v_permlane32_swap_b32 v40, v42
    v_add_f32 v40, v40, v42
    v_cmp_ne_u32 vcc, 0, v69
    v_mov_b32 v41, v40
    s_cbranch_vccnz L_h35
L_h35_done:
    s_nop 0
    v_permlane16_swap_b32 v40, v41
    v_add_f32 v40, v40, v41
    v_mul_f32 v40, v40, v48
    v_cvt_pk_bf16_f32 v40, 0, v40
    v_mov_b32 v42, v40
    v_mul_f32 v41, s50, v40
    v_exp_f32 v41, -v41
    v_permlane32_swap_b32 v40, v42
    v_add_f32 v41, 1.0, v41
    v_rcp_f32 v41, v41
    s_cmp_lg_u32 s57, s85
    v_mul_f32 v41, v40, v41
    v_cvt_pk_bf16_f32 v41, 0, v41
    v_mul_f32 v41, v41, v42
    v_cvt_pk_bf16_f32 v41, 0, v41
    s_mov_b64 exec, 0xffff
    ds_write_b16_d16_hi v158, v41
    s_mov_b64 exec, -1
    s_waitcnt lgkmcnt(0)
    s_barrier
    ds_read2_b64 v[40:43], v159 offset0:0 offset1:4
    ds_read2_b64 v[44:47], v159 offset0:8 offset1:12
    s_waitcnt lgkmcnt(1)
    v_mfma_f32_16x16x32_bf16 v[72:75], v[56:59], v[40:43], 0
    s_waitcnt lgkmcnt(0)
    v_mfma_f32_16x16x32_bf16 v[72:75], v[60:63], v[44:47], v[72:75]
    v_cmp_gt_u32 vcc, 48, v0
    s_nop 6
    v_and_or_b32 v80, v72, s73, v162
    v_and_or_b32 v81, v73, s73, v163
    v_and_or_b32 v82, v74, s73, v164
    v_and_or_b32 v83, v75, s73, v165
    buffer_store_dwordx4 v[80:83], v131, s[44:47], s20 offen sc1
    s_cbranch_scc1 L_exit
    v_and_b32 v40, 7, v0
    v_lshrrev_b32 v41, 3, v0
    v_lshlrev_b32 v41, 8, v41
    v_lshl_add_u32 v64, v40, 3, v41
    v_cmp_gt_u32 vcc, 32, v0
    v_mov_b32 v41, 0x80000000
    v_add_u32 v65, 0x1000, v64
    v_lshrrev_b32 v42, 5, v0
    v_lshl_add_u32 v42, v40, 1, v42
    v_cndmask_b32 v66, v41, v65, vcc
    s_lshl_b32 s60, s3, 4
    v_add_u32 v42, s60, v42
    v_lshlrev_b32 v42, 1, v42
    v_add_u32 v43, 77824, v42
    ds_read_u16 v67, v43
    s_lshl_b32 s60, s58, 7
    v_add_u32 v70, s60, v42
    v_and_b32 v40, 1, v0
    v_cmp_eq_u32 s[62:63], 1, v40
    v_mov_b32 v48, 0
    v_mov_b32 v49, 0
    v_cndmask_b32 v56, v162, v164, s[62:63]
    v_cndmask_b32 v57, v163, v165, s[62:63]
    v_cndmask_b32 v58, 0, v56, vcc
    v_cndmask_b32 v59, 0, v57, vcc
    s_mov_b32 s72, 1000000
    v_pk_mul_f32 v[72:73], v[48:49], v[48:49]
    v_pk_mul_f32 v[74:75], v[48:49], v[48:49]
    v_pk_mul_f32 v[76:77], v[48:49], v[48:49]
    v_pk_mul_f32 v[78:79], v[48:49], v[48:49]
    buffer_atomic_or_x2 v[72:73], v64, s[44:47], s21 offen sc0 sc1
    buffer_atomic_or_x2 v[74:75], v64, s[44:47], s21 offen offset:2048 sc0 sc1
    buffer_atomic_or_x2 v[76:77], v65, s[44:47], s21 offen sc0 sc1
    buffer_atomic_or_x2 v[78:79], v66, s[44:47], s21 offen offset:2048 sc0 sc1
L_h4:
    s_sub_u32 s72, s72, 1
    s_cbranch_scc1 L_h4_done
    v_pk_mul_f32 v[80:81], v[48:49], v[48:49]
    v_pk_mul_f32 v[82:83], v[48:49], v[48:49]
    v_pk_mul_f32 v[84:85], v[48:49], v[48:49]
    v_pk_mul_f32 v[86:87], v[48:49], v[48:49]
    buffer_atomic_or_x2 v[80:81], v64, s[44:47], s21 offen sc0 sc1
    buffer_atomic_or_x2 v[82:83], v64, s[44:47], s21 offen offset:2048 sc0 sc1
    buffer_atomic_or_x2 v[84:85], v65, s[44:47], s21 offen sc0 sc1
    buffer_atomic_or_x2 v[86:87], v66, s[44:47], s21 offen offset:2048 sc0 sc1
    s_waitcnt vmcnt(4)
    v_xor_b32 v40, v56, v72
    v_xor_b32 v41, v57, v73
    v_xor_b32 v42, v56, v74
    v_xor_b32 v43, v57, v75
    v_xor_b32 v44, v56, v76
    v_xor_b32 v45, v57, v77
    v_xor_b32 v46, v58, v78
    v_xor_b32 v47, v59, v79
    v_or3_b32 v69, v40, v41, v42
    v_or3_b32 v69, v69, v43, v44
    v_or3_b32 v69, v69, v45, v46
    v_pk_add_f32 v[40:41], v[40:41], v[42:43]
    v_or_b32 v69, v69, v47
    v_pk_add_f32 v[44:45], v[44:45], v[46:47]
    v_and_b32 v69, 0xff, v69
    v_pk_add_f32 v[40:41], v[40:41], v[44:45]
    v_cmp_ne_u32 vcc, 0, v69
    s_cbranch_vccz L_h4_done
    v_pk_mul_f32 v[72:73], v[48:49], v[48:49]
    v_pk_mul_f32 v[74:75], v[48:49], v[48:49]
    v_pk_mul_f32 v[76:77], v[48:49], v[48:49]
    v_pk_mul_f32 v[78:79], v[48:49], v[48:49]
    buffer_atomic_or_x2 v[72:73], v64, s[44:47], s21 offen sc0 sc1
    buffer_atomic_or_x2 v[74:75], v64, s[44:47], s21 offen offset:2048 sc0 sc1
    buffer_atomic_or_x2 v[76:77], v65, s[44:47], s21 offen sc0 sc1
    buffer_atomic_or_x2 v[78:79], v66, s[44:47], s21 offen offset:2048 sc0 sc1
    s_waitcnt vmcnt(4)
    v_xor_b32 v40, v56, v80
    v_xor_b32 v41, v57, v81
    v_xor_b32 v42, v56, v82
    v_xor_b32 v43, v57, v83
    v_xor_b32 v44, v56, v84
    v_xor_b32 v45, v57, v85
    v_xor_b32 v46, v58, v86
    v_xor_b32 v47, v59, v87
    v_or3_b32 v69, v40, v41, v42
    v_or3_b32 v69, v69, v43, v44
    v_or3_b32 v69, v69, v45, v46
    v_pk_add_f32 v[40:41], v[40:41], v[42:43]
    v_or_b32 v69, v69, v47
    v_pk_add_f32 v[44:45], v[44:45], v[46:47]
    v_and_b32 v69, 0xff, v69
    v_pk_add_f32 v[40:41], v[40:41], v[44:45]
    v_cmp_ne_u32 vcc, 0, v69
    s_cbranch_vccnz L_h4
L_h4_done:
    s_nop 0
    v_permlane32_swap_b32 v40, v41
    v_add_f32 v40, v40, v41
    v_mov_b32 v41, v40
    s_waitcnt lgkmcnt(0)
    v_lshlrev_b32 v67, 16, v67
    v_permlane16_swap_b32 v40, v41
    v_add_f32 v40, v40, v41
    s_nop 1
    v_add_f32_dpp v40, v40, v40 row_ror:8 row_mask:0xf bank_mask:0xf
    v_cvt_pk_bf16_f32 v40, 0, v40
    v_add_f32 v40, v40, v67
    v_cvt_pk_bf16_f32 v40, 0, v40
    buffer_store_short_d16_hi v40, v70, s[40:43], 0 offen
    s_or_b32 s60, s58, s3
    s_cmp_lg_u32 s60, 0
    s_cbranch_scc1 L_exit
    buffer_store_dword v156, v148, s[44:47], 0 offen
L_exit:
L_end:
    s_endpgm
    .p2align 12
L_pad_z1:
    s_setpc_b64 s[70:71]
L_Z:
    v_lshlrev_b32 v7, 4, v0
    s_waitcnt lgkmcnt(0)
    s_and_b32 s58, s5, 7
    s_lshr_b32 s60, s5, 3
    s_lshl_b32 s61, s4, 2
    s_mul_i32 s62, s4, 3
    s_add_u32 s62, s62, 4
    s_cmp_lt_u32 s4, 4
    s_cselect_b32 s61, s61, s62
    s_cselect_b32 s63, 4, 3
    s_add_u32 s57, s61, s60
    s_cmp_lt_u32 s60, s63
    s_cselect_b32 s59, 1, 0
    s_lshl_b32 s64, s4, 15
    s_lshl_b32 s60, s5, 10
    s_add_u32 s64, s64, s60
    s_add_u32 s64, s64, 0x80000
    s_lshl_b32 s61, s57, 13
    s_lshl_b32 s60, s58, 10
    s_add_u32 s61, s61, s60
    s_add_u32 s61, s61, 0x27c00
    s_lshl_b32 s62, s4, 5
    s_add_u32 s62, s62, s5
    s_mul_i32 s62, s62, 384
    s_add_u32 s62, s62, 0xdf800
    s_lshl_b32 s63, s57, 7
    s_add_u32 s63, s63, 0x5f680
    s_lshl_b32 s65, s4, 13
    s_lshl_b32 s60, s5, 8
    s_add_u32 s65, s65, s60
    s_add_u32 s65, s65, 0x600
    s_lshl_b32 s77, s4, 7
    s_add_u32 s77, s77, 0x7b500
    v_mov_b32 v8, 0x7fffff00
    v_cmp_gt_u32 vcc, 23, v0
    v_mov_b32 v1, s77
    s_nop 0
    v_cndmask_b32 v8, v8, v1, vcc
    v_cmp_gt_u32 vcc, 22, v0
    v_mov_b32 v1, s65
    s_nop 0
    v_cndmask_b32 v8, v8, v1, vcc
    v_mov_b32 v1, s63
    v_cmp_gt_u32 vcc, 20, v0
    v_mov_b32 v2, s62
    v_mov_b32 v3, s61
    v_cndmask_b32 v8, v8, v1, vcc
    v_cmp_gt_u32 vcc, 19, v0
    v_mov_b32 v4, s64
    s_mov_b32 s73, 0xffffff00
    v_cndmask_b32 v8, v8, v2, vcc
    v_cmp_gt_u32 vcc, 16, v0
    v_lshrrev_b32 v1, 4, v0
    v_lshlrev_b32 v14, 3, v1
    v_cndmask_b32 v8, v8, v3, vcc
    v_cmp_gt_u32 vcc, 8, v0
    v_lshlrev_b32 v1, 7, v0
    v_mov_b32 v3, 0x3f803f80
    v_cndmask_b32 v8, v8, v4, vcc
    v_add_u32 v8, v8, v1
    v_and_b32 v4, 31, v0
    v_lshlrev_b32 v4, 2, v4
    v_add_u32 v4, 77952, v4
    ds_write_b32 v4, v3
    v_mov_b32 v4, 76176
    v_mov_b32 v3, 0
    ds_write_b32 v4, v3
    v_add_u32 v1, 65536, v7
    s_barrier
    ds_read_b128 v[16:19], v1
    buffer_load_dword v9, v8, s[44:47], 0 offen sc1
    s_waitcnt lgkmcnt(0)
    v_lshlrev_b32 v20, 16, v16
    v_and_b32 v21, 0xffff0000, v16
    v_lshlrev_b32 v22, 16, v17
    v_and_b32 v23, 0xffff0000, v17
    v_lshlrev_b32 v24, 16, v18
    v_and_b32 v25, 0xffff0000, v18
    v_lshlrev_b32 v26, 16, v19
    v_and_b32 v27, 0xffff0000, v19
    v_pk_add_f32 v[10:11], v[20:21], v[22:23]
    v_pk_add_f32 v[12:13], v[24:25], v[26:27]
    v_pk_add_f32 v[10:11], v[10:11], v[12:13]
    v_add_f32 v28, v10, v11
    s_nop 1
    v_add_f32_dpp v28, v28, v28 row_ror:8 row_mask:0xf bank_mask:0xf
    s_nop 1
    v_add_f32_dpp v28, v28, v28 row_ror:4 row_mask:0xf bank_mask:0xf
    s_nop 1
    v_add_f32_dpp v28, v28, v28 row_ror:2 row_mask:0xf bank_mask:0xf
    s_nop 1
    v_add_f32_dpp v28, v28, v28 row_ror:1 row_mask:0xf bank_mask:0xf
    v_mov_b32 v1, v28
    s_nop 1
    v_permlane16_swap_b32 v28, v1
    v_add_f32 v28, v28, v1
    v_mov_b32 v1, v28
    s_nop 1
    v_permlane32_swap_b32 v28, v1
    v_add_f32 v28, v28, v1
    v_mul_f32 v28, 0x3b000000, v28
    v_sub_f32 v1, v20, v28
    v_mul_f32 v29, v1, v1
    v_sub_f32 v1, v21, v28
    v_fmac_f32 v29, v1, v1
    v_sub_f32 v1, v22, v28
    v_fmac_f32 v29, v1, v1
    v_sub_f32 v1, v23, v28
    v_fmac_f32 v29, v1, v1
    v_sub_f32 v1, v24, v28
    v_fmac_f32 v29, v1, v1
    v_sub_f32 v1, v25, v28
    v_fmac_f32 v29, v1, v1
    v_sub_f32 v1, v26, v28
    v_fmac_f32 v29, v1, v1
    v_sub_f32 v1, v27, v28
    v_fmac_f32 v29, v1, v1
    v_cvt_pk_bf16_f32 v28, 0, v28
    v_sub_f32 v20, v20, v28
    v_add_f32_dpp v29, v29, v29 row_ror:8 row_mask:0xf bank_mask:0xf
    v_sub_f32 v21, v21, v28
    v_sub_f32 v22, v22, v28
    v_add_f32_dpp v29, v29, v29 row_ror:4 row_mask:0xf bank_mask:0xf
    v_sub_f32 v23, v23, v28
    v_sub_f32 v24, v24, v28
    v_add_f32_dpp v29, v29, v29 row_ror:2 row_mask:0xf bank_mask:0xf
    v_sub_f32 v25, v25, v28
    v_sub_f32 v26, v26, v28
    v_add_f32_dpp v29, v29, v29 row_ror:1 row_mask:0xf bank_mask:0xf
    v_mov_b32 v1, v29
    v_sub_f32 v27, v27, v28
    v_cvt_pk_bf16_f32 v20, 0, v20
    v_permlane16_swap_b32 v29, v1
    v_add_f32 v29, v29, v1
    v_mov_b32 v1, v29
    v_cvt_pk_bf16_f32 v21, 0, v21
    v_cvt_pk_bf16_f32 v22, 0, v22
    v_permlane32_swap_b32 v29, v1
    v_add_f32 v29, v29, v1
    v_mul_f32 v29, 0x3b000000, v29
    v_cvt_pk_bf16_f32 v29, 0, v29
    v_add_f32 v29, 0x3727c5ac, v29
    v_cvt_pk_bf16_f32 v29, 0, v29
    v_sqrt_f32 v29, v29
    v_cvt_pk_bf16_f32 v23, 0, v23
    v_cvt_pk_bf16_f32 v29, 0, v29
    v_rcp_f32 v29, v29
    v_cvt_pk_bf16_f32 v24, 0, v24
    v_cvt_pk_bf16_f32 v25, 0, v25
    v_cvt_pk_bf16_f32 v26, 0, v26
    v_cvt_pk_bf16_f32 v27, 0, v27
    v_add_u32 v1, 73728, v7
    v_pk_mul_f32 v[20:21], v[20:21], v[28:29] op_sel:[0,1] op_sel_hi:[1,1]
    v_cvt_pk_bf16_f32 v16, v20, v21
    v_pk_mul_f32 v[22:23], v[22:23], v[28:29] op_sel:[0,1] op_sel_hi:[1,1]
    v_cvt_pk_bf16_f32 v17, v22, v23
    v_pk_mul_f32 v[24:25], v[24:25], v[28:29] op_sel:[0,1] op_sel_hi:[1,1]
    v_cvt_pk_bf16_f32 v18, v24, v25
    v_pk_mul_f32 v[26:27], v[26:27], v[28:29] op_sel:[0,1] op_sel_hi:[1,1]
    v_cvt_pk_bf16_f32 v19, v26, v27
    ds_write_b128 v1, v[16:19]
    s_waitcnt lgkmcnt(0)
    s_barrier
    s_load_dword s48, s[44:45], 0
    s_waitcnt lgkmcnt(0)
    s_andn2_b32 s48, s48, 0xff
    s_mul_i32 s48, s48, 0x9e3779b1
    s_add_u32 s48, s48, 0x7f4a7d15
    s_bfe_u32 s60, s48, 0x80008
    s_lshr_b32 s61, s48, 24
    s_cmp_eq_u32 s60, s61
    s_cselect_b32 s60, 0x200, 0
    s_xor_b32 s48, s48, s60
    s_and_b32 s52, s48, 0xff
    s_bfe_u32 s53, s48, 0x80008
    s_bfe_u32 s54, s48, 0x80010
    s_lshr_b32 s55, s48, 24
    s_load_dwordx2 s[28:29], s[0:1], 48
    s_load_dwordx2 s[32:33], s[0:1], 56
    s_load_dwordx2 s[36:37], s[0:1], 64
    s_mov_b32 s30, 0x1c0000
    s_mov_b32 s31, 0x20000
    s_mov_b32 s34, 0x1c0000
    s_mov_b32 s35, 0x20000
    s_mov_b32 s38, 0x1c0000
    s_mov_b32 s39, 0x20000
    v_lshrrev_b32 v10, 4, v0
    v_lshlrev_b32 v10, 1, v10
    v_and_b32 v11, 7, v0
    v_xor_b32 v10, v10, v11
    v_lshlrev_b32 v10, 4, v10
    v_lshrrev_b32 v11, 3, v0
    v_lshl_add_u32 v12, v11, 10, v10
    v_mul_u32_u24 v13, 3584, v11
    v_add_u32 v13, v13, v10
    s_mul_i32 s76, s58, 229376
    s_lshl_b32 s60, s57, 7
    s_add_u32 s76, s76, s60
    s_lshl_b32 s77, s57, 16
    s_lshl_b32 s60, s58, 7
    s_add_u32 s77, s77, s60
    s_waitcnt lgkmcnt(0)
    s_barrier
    s_barrier
    s_and_b32 s65, s5, 7
    s_lshr_b32 s64, s5, 3
    s_lshl_b32 s67, s65, 13
    s_lshl_b32 s60, s4, 10
    s_add_u32 s67, s67, s60
    s_lshl_b32 s60, s64, 8
    s_add_u32 s67, s67, s60
    s_add_u32 s67, s67, 0x100000
    s_lshl_b32 s66, s57, 7
    s_lshl_b32 s60, s58, 4
    s_add_u32 s66, s66, s60
    s_add_u32 s66, s66, 0x60000
    s_lshl_b32 s61, s4, 12
    s_lshl_b32 s60, s58, 9
    s_add_u32 s61, s61, s60
    s_add_u32 s61, s61, 0xd0000
    s_add_u32 s42, s44, s61
    s_addc_u32 s43, s45, 0
    s_lshl_b32 s61, s58, 9
    s_add_u32 s61, s61, 0x26000
    s_add_u32 s64, s44, s61
    s_addc_u32 s65, s45, 0
    s_add_u32 s68, s67, 262144
    v_and_b32 v30, 15, v0
    v_lshlrev_b32 v30, 4, v30
    v_lshrrev_b32 v31, 4, v0
    v_lshl_add_u32 v31, v31, 16, v30
    v_add_u32 v30, 76800, v30
    v_mov_b32 v60, s52
    v_mov_b32 v61, s53
    v_mov_b32 v62, s54
    v_mov_b32 v63, s55
    v_mov_b32 v20, 76160
    v_mov_b32 v21, 76176
    v_and_b32 v1, 15, v0
    v_cmp_eq_u32 vcc, 1, v1
    v_mov_b32 v2, 77824
    v_mov_b32 v3, 77952
    v_add_u32 v65, 77824, v14
    v_cndmask_b32 v2, v2, v3, vcc
    v_add_u32 v64, v2, v14
    v_cmp_eq_u32 vcc, 0, v0
    v_mov_b32 v2, 0x80000000
    v_mov_b32 v54, s48
    v_mov_b32 v55, s48
    v_cndmask_b32 v66, v2, 0, vcc
    s_barrier
    buffer_load_dword v9, v8, s[44:47], 0 offen sc1
    ds_read_b128 v[24:27], v20
    s_waitcnt lgkmcnt(0)
    v_and_b32 v24, v24, v25
    v_and_b32 v26, v26, v27
    v_and_b32 v24, v24, v26
    s_nop 0
    v_readfirstlane_b32 s56, v24
    v_cmp_gt_u32 vcc, 8, v0
    s_lshr_b32 s60, s5, 3
    s_cmp_eq_u32 s60, 0
    s_cselect_b64 vcc, vcc, 0
    v_mov_b32 v22, 0x80000000
    v_lshlrev_b32 v23, 12, v0
    v_cndmask_b32 v22, v22, v23, vcc
    s_and_b32 s61, s5, 7
    s_lshl_b32 s69, s61, 9
    s_lshl_b32 s60, s4, 2
    s_add_u32 s69, s69, s60
    s_add_u32 s69, s69, 0xd0000
    s_barrier
    s_barrier
    s_barrier
    s_cmp_eq_u32 s59, 0
    s_cbranch_scc1 L_z_nof
    s_mov_b32 m0, 49152
    s_add_u32 s60, s76, 0
    buffer_load_dwordx4 v13, s[28:31], s60 offen nt lds
    s_mov_b32 m0, 50176
    s_add_u32 s60, s76, 28672
    buffer_load_dwordx4 v13, s[28:31], s60 offen nt lds
    s_mov_b32 m0, 51200
    s_add_u32 s60, s76, 57344
    buffer_load_dwordx4 v13, s[28:31], s60 offen nt lds
    s_mov_b32 m0, 52224
    s_add_u32 s60, s76, 86016
    buffer_load_dwordx4 v13, s[28:31], s60 offen nt lds
    s_mov_b32 m0, 53248
    s_add_u32 s60, s76, 114688
    buffer_load_dwordx4 v13, s[28:31], s60 offen nt lds
    s_mov_b32 m0, 54272
    s_add_u32 s60, s76, 143360
    buffer_load_dwordx4 v13, s[28:31], s60 offen nt lds
    s_mov_b32 m0, 55296
    s_add_u32 s60, s76, 172032
    buffer_load_dwordx4 v13, s[28:31], s60 offen nt lds
    s_mov_b32 m0, 56320
    s_add_u32 s60, s76, 200704
    buffer_load_dwordx4 v13, s[28:31], s60 offen nt lds
    s_mov_b32 m0, 57344
    s_add_u32 s60, s76, 0
    buffer_load_dwordx4 v13, s[32:35], s60 offen nt lds
    s_mov_b32 m0, 58368
    s_add_u32 s60, s76, 28672
    buffer_load_dwordx4 v13, s[32:35], s60 offen nt lds
    s_mov_b32 m0, 59392
    s_add_u32 s60, s76, 57344
    buffer_load_dwordx4 v13, s[32:35], s60 offen nt lds
    s_mov_b32 m0, 60416
    s_add_u32 s60, s76, 86016
    buffer_load_dwordx4 v13, s[32:35], s60 offen nt lds
    s_mov_b32 m0, 61440
    s_add_u32 s60, s76, 114688
    buffer_load_dwordx4 v13, s[32:35], s60 offen nt lds
    s_mov_b32 m0, 62464
    s_add_u32 s60, s76, 143360
    buffer_load_dwordx4 v13, s[32:35], s60 offen nt lds
    s_mov_b32 m0, 63488
    s_add_u32 s60, s76, 172032
    buffer_load_dwordx4 v13, s[32:35], s60 offen nt lds
    s_mov_b32 m0, 64512
    s_add_u32 s60, s76, 200704
    buffer_load_dwordx4 v13, s[32:35], s60 offen nt lds
L_z_nof:
    s_barrier
    ds_read_b128 v[32:35], v30 offset:0
    ds_read_b128 v[36:39], v30 offset:256
    ds_read_b128 v[40:43], v30 offset:512
    ds_read_b128 v[44:47], v30 offset:768
    buffer_store_dword v54, v22, s[44:47], s69 offen sc1
    s_waitcnt lgkmcnt(2)
    v_pk_add_f32 v[32:33], v[32:33], v[36:37]
    v_pk_add_f32 v[34:35], v[34:35], v[38:39]
    s_waitcnt lgkmcnt(0)
    v_pk_add_f32 v[40:41], v[40:41], v[44:45]
    v_pk_add_f32 v[42:43], v[42:43], v[46:47]
    v_pk_add_f32 v[32:33], v[32:33], v[40:41]
    v_pk_add_f32 v[34:35], v[34:35], v[42:43]
    v_and_or_b32 v32, v32, s73, v60
    v_and_or_b32 v33, v33, s73, v61
    v_and_or_b32 v34, v34, s73, v62
    v_and_or_b32 v35, v35, s73, v63
    buffer_store_dwordx4 v[32:35], v31, s[44:47], s67 offen sc1
    buffer_store_dwordx4 v[32:35], v31, s[44:47], s68 offen sc1
    s_cmp_eq_u32 s59, 0
    s_cbranch_scc1 L_exit
    s_mov_b32 m0, 65536
    s_add_u32 s60, s77, 0
    buffer_load_dwordx4 v12, s[36:39], s60 offen nt lds
    s_mov_b32 m0, 66560
    s_add_u32 s60, s77, 8192
    buffer_load_dwordx4 v12, s[36:39], s60 offen nt lds
    s_mov_b32 m0, 67584
    s_add_u32 s60, s77, 16384
    buffer_load_dwordx4 v12, s[36:39], s60 offen nt lds
    s_mov_b32 m0, 68608
    s_add_u32 s60, s77, 24576
    buffer_load_dwordx4 v12, s[36:39], s60 offen nt lds
    s_mov_b32 m0, 69632
    s_add_u32 s60, s77, 32768
    buffer_load_dwordx4 v12, s[36:39], s60 offen nt lds
    s_mov_b32 m0, 70656
    s_add_u32 s60, s77, 40960
    buffer_load_dwordx4 v12, s[36:39], s60 offen nt lds
    s_mov_b32 m0, 71680
    s_add_u32 s60, s77, 49152
    buffer_load_dwordx4 v12, s[36:39], s60 offen nt lds
    s_mov_b32 m0, 72704
    s_add_u32 s60, s77, 57344
    buffer_load_dwordx4 v12, s[36:39], s60 offen nt lds
    s_mov_b32 s40, s48
    s_mov_b32 s41, s48
    s_mov_b32 s72, 1000000
L_f3:
    s_sub_u32 s72, s72, 1
    s_cbranch_scc1 L_f3_done
    s_sleep 1
    s_load_dwordx8 s[8:15], s[42:43], 0 glc
    s_waitcnt lgkmcnt(0)
    s_xor_b64 s[8:9], s[8:9], s[40:41]
    s_xor_b64 s[10:11], s[10:11], s[40:41]
    s_or_b64 s[8:9], s[8:9], s[10:11]
    s_xor_b64 s[12:13], s[12:13], s[40:41]
    s_or_b64 s[8:9], s[8:9], s[12:13]
    s_xor_b64 s[14:15], s[14:15], s[40:41]
    s_or_b64 s[8:9], s[8:9], s[14:15]
    s_cbranch_scc1 L_f3
L_f3_done:
    s_barrier
    s_waitcnt vmcnt(11)
    s_barrier
    s_cmp_eq_u32 s56, 0
    s_barrier
    ds_read2_b64 v[32:35], v64 offset0:0 offset1:4
    ds_read2_b64 v[36:39], v65 offset0:0 offset1:4
    ds_read2_b64 v[40:43], v64 offset0:8 offset1:12
    ds_read2_b64 v[44:47], v65 offset0:8 offset1:12
    s_waitcnt lgkmcnt(2)
    v_mfma_f32_16x16x32_bf16 v[48:51], v[32:35], v[36:39], 0
    s_waitcnt lgkmcnt(0)
    v_mfma_f32_16x16x32_bf16 v[48:51], v[40:43], v[44:47], v[48:51]
    s_nop 7
    v_mov_b32 v52, v48
    v_mov_b32 v53, v49
    s_cbranch_scc1 L_slow4
    buffer_store_dwordx4 v[52:55], v66, s[44:47], s66 offen
L_back4:
    s_waitcnt vmcnt(1)
    s_barrier
    s_branch L_exit
L_pad_tail:
    s_setpc_b64 s[70:71]
L_h1_retry:
    s_mov_b32 s72, 1000000
L_h1:
    s_sub_u32 s72, s72, 1
    s_cbranch_scc1 L_h1_done
    s_cmp_eq_u32 s72, 999996
    s_cselect_b32 s60, 0xbf000, 0
    s_add_u32 s79, s79, s60
    buffer_load_dwordx4 v[132:135], v129, s[44:47], s79 offen sc1
    buffer_load_dwordx4 v[136:139], v129, s[44:47], s79 offen offset:2048 sc1
    s_waitcnt vmcnt(0)
    v_xor_b32 v132, s75, v132
    v_xor_b32 v136, s75, v136
    v_xor_b32 v133, s53, v133
    v_xor_b32 v137, s53, v137
    v_xor_b32 v134, s54, v134
    v_xor_b32 v138, s54, v138
    v_xor_b32 v135, s55, v135
    v_xor_b32 v139, s55, v139
    v_or_b32 v140, v132, v136
    v_or3_b32 v141, v133, v134, v135
    v_and_b32 v132, s73, v132
    v_and_b32 v136, s73, v136
    v_or3_b32 v141, v141, v137, v138
    v_and_b32 v36, 0xf0, v140
    v_or3_b32 v141, v141, v139, v36
    v_pk_add_f32 v[132:133], v[132:133], v[136:137]
    v_pk_add_f32 v[134:135], v[134:135], v[138:139]
    v_and_b32 v141, 0xff, v141
    v_cmp_ne_u32 vcc, 0, v141
    s_cbranch_vccnz L_h1
    s_branch L_h1_done
L_slow0:
    buffer_store_dword v36, v161, s[44:47], s81 offen sc1
    s_branch L_back0
L_slow1:
    buffer_store_dword v37, v153, s[44:47], s71 offen sc1
    s_branch L_back1
L_slow2:
    buffer_store_dwordx4 v[144:147], v148, s[44:47], s82 offen sc1
    s_branch L_back2
L_h2_retry:
    s_mov_b32 s72, 1000000
L_h2:
    s_sub_u32 s72, s72, 1
    s_cbranch_scc1 L_h2_done
    buffer_load_dwordx4 v[40:43], v17, s[44:47], s83 offen sc1
    buffer_load_dword v52, v166, s[44:47], s23 offen offset:512 sc1
    buffer_load_dwordx4 v[44:47], v150, s[44:47], s83 offen sc1
    buffer_load_dword v53, v166, s[44:47], s23 offen offset:576 sc1
    s_waitcnt vmcnt(3)
    v_mfma_f32_16x16x32_bf16 v[88:91], v[40:43], v[72:75], 0
    v_mfma_f32_16x16x32_bf16 v[92:95], v[40:43], v[76:79], 0
    v_bitop3_b32 v36, v40, v41, v42 bitop3:0x96
    v_mfma_f32_16x16x32_bf16 v[96:99], v[40:43], v[80:83], 0
    s_waitcnt vmcnt(2)
    v_mfma_f32_16x16x32_bf16 v[100:103], v[40:43], v[84:87], 0
    v_bitop3_b32 v36, v36, v43, v52 bitop3:0x96
    s_waitcnt vmcnt(1)
    v_mfma_f32_16x16x32_bf16 v[104:107], v[44:47], v[72:75], 0
    v_cmp_ne_u32 s[62:63], s48, v36
    v_mfma_f32_16x16x32_bf16 v[108:111], v[44:47], v[76:79], 0
    v_bitop3_b32 v37, v44, v45, v46 bitop3:0x96
    v_mfma_f32_16x16x32_bf16 v[112:115], v[44:47], v[80:83], 0
    v_pk_mul_f32 v[56:57], v[120:121], v[88:89]
    v_mfma_f32_16x16x32_bf16 v[116:119], v[44:47], v[84:87], 0
    v_pk_mul_f32 v[58:59], v[120:121], v[92:93]
    s_waitcnt vmcnt(0)
    v_bitop3_b32 v37, v37, v47, v53 bitop3:0x96
    v_pk_mul_f32 v[60:61], v[120:121], v[96:97]
    v_pk_mul_f32 v[62:63], v[120:121], v[100:101]
    v_cmp_ne_u32 s[64:65], s48, v37
    v_pk_fma_f32 v[56:57], v[122:123], v[90:91], v[56:57]
    v_pk_fma_f32 v[58:59], v[122:123], v[94:95], v[58:59]
    v_pk_fma_f32 v[60:61], v[122:123], v[98:99], v[60:61]
    v_pk_fma_f32 v[62:63], v[122:123], v[102:103], v[62:63]
    s_or_b64 vcc, s[62:63], s[64:65]
    s_cbranch_scc1 L_h2
    s_branch L_h2_done
L_h3_retry:
    s_mov_b32 s72, 1000000
L_h3:
    s_sub_u32 s72, s72, 1
    s_cbranch_scc1 L_h3_done
    buffer_load_dwordx4 v[40:43], v27, s[44:47], s8 offen sc1
    buffer_load_dwordx4 v[44:47], v151, s[44:47], s8 offen sc1
    s_waitcnt vmcnt(1)
    v_xor_b32 v40, s52, v40
    v_xor_b32 v41, s53, v41
    v_xor_b32 v42, s54, v42
    v_xor_b32 v43, s55, v43
    v_or3_b32 v69, v40, v41, v42
    s_waitcnt vmcnt(0)
    v_xor_b32 v44, s52, v44
    v_xor_b32 v45, s53, v45
    v_xor_b32 v46, s54, v46
    v_xor_b32 v47, s55, v47
    v_or3_b32 v69, v69, v43, v44
    v_pk_add_f32 v[40:41], v[40:41], v[44:45]
    v_pk_add_f32 v[42:43], v[42:43], v[46:47]
    v_or3_b32 v69, v69, v45, v46
    v_or_b32 v69, v69, v47
    v_permlane32_swap_b32 v40, v42
    v_permlane32_swap_b32 v41, v43
    v_add_f32 v40, v40, v42
    v_add_f32 v41, v41, v43
    v_and_b32 v69, 0xff, v69
    v_cmp_ne_u32 vcc, 0, v69
    v_permlane16_swap_b32 v40, v41
    v_add_f32 v40, v40, v41
    s_nop 1
    v_add_f32_dpp v40, v40, v40 row_ror:8 row_mask:0xf bank_mask:0xf
    s_cbranch_vccnz L_h3
    s_branch L_h3_done
L_slow3:
    buffer_store_dwordx4 v[80:83], v32, s[44:47], s9 offen sc1
    s_branch L_back3
L_h35_w:
    s_waitcnt vmcnt(0)
    s_branch L_h35
L_slow4:
    buffer_store_dwordx4 v[52:55], v66, s[44:47], s66 offen sc1
    s_branch L_back4
.section .rodata,"a"
.p2align 6
.amdhsa_kernel sequential_preLN__sliding_block_cached__glu_gated_swiglu__decode_kernel
  .amdhsa_next_free_vgpr 168
  .amdhsa_next_free_sgpr 102
  .amdhsa_accum_offset 168
  .amdhsa_group_segment_fixed_size 0
  .amdhsa_kernarg_size 96
  .amdhsa_user_sgpr_count 2
  .amdhsa_user_sgpr_kernarg_segment_ptr 1
  .amdhsa_system_sgpr_workgroup_id_x 1
  .amdhsa_float_denorm_mode_32 3
.end_amdhsa_kernel
```
